```python
import torch

def _softmax(x, axis=-1):
    return torch.softmax(x, dim=axis)
def _gelu(x):
    return torch.nn.functional.gelu(x, approximate="tanh")
def _silu(x):
    return torch.nn.functional.silu(x)
def _sigmoid(x):
    return torch.sigmoid(x)
def _layernorm(x, axis=-1, eps=1e-5):
    m = x.mean(dim=axis, keepdim=True)
    v = x.var(dim=axis, keepdim=True, unbiased=False)
    return (x - m) / torch.sqrt(v + eps)
def _scatter_add(tgt, idx, src, axis=0):
    return tgt.clone().index_add_(axis, idx, src)
def _segment_sum(src, seg, n):
    out = torch.zeros((n,) + src.shape[1:], dtype=src.dtype)
    return out.index_add_(0, seg, src)
def _pad(x, pw):
    flat = tuple(v for pair in reversed(pw) for v in pair)
    return torch.nn.functional.pad(x, flat)

kernel_name = 'standalone__grouped__vision'

def setup_inputs():

    _w = (lambda a: (lambda t: t.to(torch.bfloat16) if t.is_floating_point() else t)(torch.as_tensor(a)))
    H = W = 384
    G = 4
    Cg = max(96 // G, 2)
    C = G * Cg
    k = 3
    scale = 1.0 / (k * Cg ** 0.5)
    return {
        "x": _w((lambda *s: torch.randn(*s, dtype=torch.bfloat16) * 0.05)(1, H, W, C)),
        "w": _w((lambda *s: torch.randn(*s, dtype=torch.bfloat16) * 0.05)(k, k, G, Cg, Cg) * scale),
    }

def reference(x, w):
    B, H, W, C = x.shape
    k = w.shape[0]
    G = w.shape[2]
    Cg = C // G
    pad = k // 2
    xp = _pad(x, ((0,0),(pad,pad),(pad,pad),(0,0)))
    xg = xp.reshape(B, H + 2 * pad, W + 2 * pad, G, Cg)
    out = torch.zeros_like(x).reshape(B, H, W, G, Cg)
    for i in range(k):
        for j in range(k):
            out = out + torch.einsum('bhwgc,gcd->bhwgd', xg[:, i:i+H, j:j+W, :, :], w[i, j])
    return out.reshape(B, H, W, C)
```

```asm
; @launch grid=(256,1,1) block=(512,1,1) lds=163840
.amdgcn_target "amdgcn-amd-amdhsa--gfx950"
.text
.globl standalone__grouped__vision_kernel
.p2align 8
.type standalone__grouped__vision_kernel,@function
standalone__grouped__vision_kernel:
    s_cmp_ge_u32 s2, 256
    s_cbranch_scc1 L_end
    s_load_dwordx4 s[4:7], s[0:1], 0
    s_load_dwordx2 s[8:9], s[0:1], 16
    v_lshrrev_b32 v1, 6, v0
    v_and_b32 v0, 63, v0
    v_mov_b32 v3, 163584
    v_readfirstlane_b32 s3, v1
    v_xor_b32 v2, 4, v1
    v_lshl_add_u32 v8, v2, 2, v3
    v_mov_b32 v2, 0
    ds_write_b32 v8, v2
    v_and_b32 v2, 3, v0
    v_lshl_add_u32 v9, v2, 2, v3
    s_bfe_u32 s26, s2, 0x10005
    s_bfe_u32 s43, s2, 0x10003
    s_cmp_lt_u32 s3, 4
    s_cbranch_scc1 L_compute
L_helper:
    s_and_b32 s10, s2, 1
    s_lshl_b32 s10, s10, 2
    s_bfe_u32 s11, s2, 0x20003
    s_add_u32 s10, s10, s11
    s_bfe_u32 s11, s2, 0x20001
    s_lshl_b32 s11, s11, 3
    s_lshr_b32 s24, s2, 5
    s_add_u32 s11, s11, s24
    s_mul_i32 s25, s11, 12
    s_mul_i32 s24, s10, 9216
    s_and_b32 s30, s3, 1
    s_bfe_u32 s45, s3, 0x10001
    v_lshrrev_b32 v1, 2, v0
    v_bfrev_b32 v3, 1
    s_mul_i32 s33, s45, 256
    s_mul_i32 s28, s43, 96
    s_add_u32 s33, s33, s28
    s_lshr_b32 s28, s33, 2
    s_add_u32 s28, s28, 2
    v_add_u32 v4, s28, v1
    s_lshl_b32 s33, s33, 4
    v_mul_u32_u24 v2, 171, v4
    v_bfe_u32 v2, v2, 11, 2
    v_xor_b32 v2, v2, v0
    v_lshl_add_u32 v10, v2, 4, s33
    v_add_u32 v2, 16, v4
    v_mul_u32_u24 v2, 171, v2
    v_bfe_u32 v2, v2, 11, 2
    v_xor_b32 v2, v2, v0
    v_lshl_add_u32 v11, v2, 4, s33
    v_add_u32 v2, 32, v4
    v_mul_u32_u24 v2, 171, v2
    v_bfe_u32 v2, v2, 11, 2
    v_xor_b32 v2, v2, v0
    v_lshl_add_u32 v12, v2, 4, s33
    v_add_u32 v2, 48, v4
    v_mul_u32_u24 v2, 171, v2
    v_bfe_u32 v2, v2, 11, 2
    v_xor_b32 v2, v2, v0
    v_lshl_add_u32 v13, v2, 4, s33
    s_add_u32 s28, s45, s10
    s_cmp_eq_u32 s28, 0
    s_cselect_b32 s32, 16, 0
    v_cmp_gt_u32 vcc, s32, v0
    s_mul_i32 s32, s30, 9728
    s_add_u32 s33, s33, s32
    v_cndmask_b32 v10, v10, v3, vcc
    s_cmp_eq_u32 s28, 8
    s_cselect_b32 s28, 48, 64
    v_cmp_le_u32 vcc, s28, v0
    s_nop 1
    v_cndmask_b32 v13, v13, v3, vcc
    s_cmp_eq_u32 s26, 0
    s_cselect_b32 s27, 1, -1
    s_cselect_b32 s29, -1, 12
    s_mul_i32 s27, s27, 73728
    s_add_i32 s29, s29, s25
    s_mul_i32 s29, s29, 73728
    s_mul_i32 s28, s30, s27
    s_add_i32 s29, s29, s28
    s_lshl_b32 s35, s27, 1
    s_bfe_u32 s44, s2, 0x20003
    s_lshl_b32 s44, s44, 3
    s_lshr_b32 s44, 0x4030201, s44
    s_and_b32 s44, s44, 255
    v_add_u32 v7, 16, v9
    s_waitcnt lgkmcnt(0)
    s_sub_u32 s12, s4, 256
    s_subb_u32 s13, s5, 0
    s_mov_b32 s14, 28311808
    s_mov_b32 s15, 0x20000
    v_mov_b32 v6, -8
    s_mov_b32 s31, s29
    s_mov_b32 s32, 0
L_ld_loop0:
    s_add_u32 s34, s31, s24
    s_cmp_lt_i32 s31, 0
    s_cselect_b32 s34, 0x40000000, s34
    s_mov_b32 m0, s33
    s_add_i32 s31, s31, s35
    s_waitcnt vmcnt(8)
    ds_write_b32 v8, v6
    buffer_load_dwordx4 v10, s[12:15], s34 offen offset:0 nt lds
    s_waitcnt vmcnt(8)
    buffer_load_dwordx4 v11, s[12:15], s34 offen offset:1024 nt lds
    s_waitcnt vmcnt(8)
    buffer_load_dwordx4 v12, s[12:15], s34 offen offset:2048 nt lds
    s_waitcnt vmcnt(8)
    buffer_load_dwordx4 v13, s[12:15], s34 offen offset:3072 nt lds
    v_add_u32 v6, 4, v6
    s_add_u32 s33, s33, 19456
    s_add_u32 s32, s32, 1
    s_cmp_lg_u32 s32, s44
    s_cbranch_scc1 L_ld_nobar
    s_barrier
L_ld_nobar:
    s_cmp_lg_u32 s32, 5
    s_cbranch_scc1 L_ld_nopoll
L_poll1:
    ds_read_b32 v5, v7
    s_waitcnt lgkmcnt(0)
    v_cmp_gt_i32 vcc, 1, v5
    s_cbranch_vccz L_pdone2
    s_sleep 1
    s_branch L_poll1
L_pdone2:
L_ld_nopoll:
    s_cmp_lt_u32 s32, 7
    s_cbranch_scc1 L_ld_loop0
    s_mov_b64 exec, -1
    s_mul_i32 s33, s45, 48
    s_mul_i32 s28, s43, -512
    s_add_u32 s33, s33, s28
    s_add_u32 s33, s33, 512
    s_lshr_b32 s28, s33, 2
    s_add_u32 s28, s28, 2
    v_add_u32 v4, s28, v1
    s_lshl_b32 s33, s33, 4
    v_mul_u32_u24 v2, 171, v4
    v_bfe_u32 v2, v2, 11, 2
    v_xor_b32 v2, v2, v0
    v_lshl_add_u32 v10, v2, 4, s33
    s_mul_i32 s32, s30, 9728
    s_add_u32 s33, s33, s32
    v_mov_b32 v6, 20
    s_mov_b32 s31, s29
    s_mov_b32 s32, 0
    s_mov_b32 exec_hi, 0xffff
L_ld_loop1:
    s_add_u32 s34, s31, s24
    s_cmp_lt_i32 s31, 0
    s_cselect_b32 s34, 0x40000000, s34
    s_mov_b32 m0, s33
    s_add_i32 s31, s31, s35
    s_waitcnt vmcnt(8)
    ds_write_b32 v8, v6
    buffer_load_dwordx4 v10, s[12:15], s34 offen offset:0 nt lds
    v_add_u32 v6, 1, v6
    s_add_u32 s33, s33, 19456
    s_add_u32 s32, s32, 1
    s_cmp_lt_u32 s32, 7
    s_cbranch_scc1 L_ld_loop1
    v_mov_b32 v2, 28
    s_waitcnt vmcnt(7)
    ds_write_b32 v8, v2
    v_mov_b32 v2, 30
    s_waitcnt vmcnt(5)
    ds_write_b32 v8, v2
    v_mov_b32 v2, 32
    s_waitcnt vmcnt(3)
    ds_write_b32 v8, v2
    v_mov_b32 v2, 34
    s_waitcnt vmcnt(1)
    ds_write_b32 v8, v2
L_ld_tail:
    s_mov_b64 exec, -1
    s_and_b32 s30, s3, 3
    s_mul_i32 s28, s30, 12
    s_add_u32 s28, s28, 3
    s_mul_i32 s32, s43, 6
    s_add_u32 s28, s28, s32
    v_add_u32 v2, s28, v1
    v_mul_u32_u24 v2, 171, v2
    v_bfe_u32 v2, v2, 11, 2
    v_xor_b32 v2, v2, v0
    s_mul_i32 s33, s30, 768
    s_add_u32 s28, s33, 64
    s_mul_i32 s32, s43, 6528
    s_add_u32 s28, s28, s32
    s_mul_i32 s32, s43, 6144
    s_add_u32 s24, s24, s32
    s_sub_u32 s36, 3072, s32
    s_sub_u32 s38, s36, 116736
    v_lshl_add_u32 v10, v2, 4, s28
    v_lshl_add_u32 v11, v0, 4, s33
    s_cmp_eq_u32 s26, 0
    s_cselect_b32 s29, 0, 11
    s_add_i32 s29, s29, s25
    s_mul_i32 s29, s29, 73728
    s_add_u32 s29, s29, s24
    s_mov_b32 s20, s8
    s_mov_b32 s21, s9
    s_mov_b32 s22, 28311552
    s_mov_b32 s23, 0x20000
    s_mov_b32 exec_hi, 0xffff
    v_mov_b32 v2, 35
    s_waitcnt vmcnt(0)
    ds_write_b32 v8, v2
    s_mov_b32 s37, 2
L_st_strip:
    s_mov_b32 s31, s29
    s_mov_b32 s32, 0
L_st_loop:
    v_cmp_gt_i32 vcc, s37, v5
    s_cbranch_vccz L_st_go
L_poll3:
    ds_read_b32 v5, v7
    s_waitcnt lgkmcnt(0)
    v_cmp_gt_i32 vcc, s37, v5
    s_cbranch_vccz L_pdone4
    s_sleep 2
    s_branch L_poll3
L_pdone4:
L_st_go:
    ds_read_b128 v[16:19], v10
    ds_read_b128 v[20:23], v10 offset:9728
    s_add_i32 s34, s31, s27
    v_add_u32 v10, 19456, v10
    s_add_u32 s37, s37, 1
    s_add_u32 s32, s32, 1
    s_waitcnt lgkmcnt(1)
    buffer_store_dwordx4 v[16:19], v11, s[20:23], s31 offen sc0 sc1 nt
    s_add_i32 s31, s34, s27
    s_waitcnt lgkmcnt(0)
    buffer_store_dwordx4 v[20:23], v11, s[20:23], s34 offen sc0 sc1 nt
    s_cmp_lt_u32 s32, 6
    s_cbranch_scc1 L_st_loop
    s_add_u32 s29, s29, s36
    v_add_u32 v10, s38, v10
    s_cmp_lt_u32 s37, 20
    s_cbranch_scc1 L_st_strip
    s_endpgm
L_compute:
    s_mul_i32 s28, s3, 1152
    v_lshl_add_u32 v108, v0, 4, s28
    s_movk_i32 s29, 3456
    v_add_u32 v2, 64, v0
    v_mul_u32_u24 v2, 911, v2
    v_lshrrev_b32 v2, 16, v2
    v_mad_u32_u24 v109, v2, s29, v108
    v_add_u32 v2, 128, v0
    v_mul_u32_u24 v2, 911, v2
    v_lshrrev_b32 v2, 16, v2
    v_mad_u32_u24 v110, v2, s29, v108
    v_add_u32 v2, 192, v0
    v_mul_u32_u24 v2, 911, v2
    v_lshrrev_b32 v2, 16, v2
    v_mad_u32_u24 v111, v2, s29, v108
    v_cmp_lt_u32 vcc, 23, v0
    v_bfrev_b32 v3, 1
    s_mul_i32 s33, s3, 12288
    s_add_u32 s33, s33, 114432
    v_cndmask_b32 v111, v111, v3, vcc
    s_mul_i32 s34, s26, 27648
    s_movk_i32 s35, 13824
    s_sub_u32 s36, 27648, s34
    s_waitcnt lgkmcnt(0)
    s_barrier
    s_mov_b32 s16, s6
    s_mov_b32 s17, s7
    s_mov_b32 s18, 41472
    s_mov_b32 s19, 0x20000
    s_add_u32 m0, s33, 0
    s_nop 0
    buffer_load_dwordx4 v108, s[16:19], s34 offen offset:0  lds
    buffer_load_dwordx4 v109, s[16:19], s34 offen offset:1024  lds
    buffer_load_dwordx4 v110, s[16:19], s34 offen offset:2048  lds
    buffer_load_dwordx4 v111, s[16:19], s34 offen offset:3072  lds
    s_add_u32 m0, s33, 4096
    s_nop 0
    buffer_load_dwordx4 v108, s[16:19], s35 offen offset:0  lds
    buffer_load_dwordx4 v109, s[16:19], s35 offen offset:1024  lds
    buffer_load_dwordx4 v110, s[16:19], s35 offen offset:2048  lds
    buffer_load_dwordx4 v111, s[16:19], s35 offen offset:3072  lds
    s_add_u32 m0, s33, 8192
    s_nop 0
    buffer_load_dwordx4 v108, s[16:19], s36 offen offset:0  lds
    buffer_load_dwordx4 v109, s[16:19], s36 offen offset:1024  lds
    buffer_load_dwordx4 v110, s[16:19], s36 offen offset:2048  lds
    buffer_load_dwordx4 v111, s[16:19], s36 offen offset:3072  lds
    v_and_b32 v1, 15, v0
    v_lshrrev_b32 v2, 4, v0
    s_mul_i32 s28, s3, 3
    v_and_b32 v3, 1, v2
    v_lshrrev_b32 v4, 1, v2
    v_cmp_gt_u32 vcc, 2, v2
    s_movk_i32 s29, 192
    s_movk_i32 s30, 1152
    s_mul_i32 s31, s43, 6144
    s_add_u32 s32, s31, 64
    v_mov_b32 v15, s32
    s_sub_u32 s38, 3072, s31
    s_sub_u32 s38, s38, 77824
    v_cndmask_b32 v6, 2, v2, vcc
    v_cndmask_b32 v7, v3, 2, vcc
    v_add_u32 v11, v3, v1
    v_add_u32 v12, 1, v11
    v_bfe_u32 v12, v12, 2, 2
    v_mad_u32_u24 v11, v11, s29, v15
    v_add_u32 v174, s28, v4
    v_xor_b32 v174, v174, v12
    v_lshl_add_u32 v174, v174, 4, v11
    v_add_u32 v11, v6, v1
    v_add_u32 v12, 1, v11
    v_bfe_u32 v12, v12, 2, 2
    v_mad_u32_u24 v11, v11, s29, v15
    v_add_u32 v175, s28, v7
    v_xor_b32 v175, v175, v12
    v_lshl_add_u32 v175, v175, 4, v11
    v_mul_u32_u24 v13, 9728, v2
    v_mov_b32 v14, 2
    v_add_u32 v11, 2, v1
    v_add_u32 v12, 1, v11
    v_bfe_u32 v12, v12, 2, 2
    v_mad_u32_u24 v11, v11, s29, v15
    v_add_u32 v176, s28, v14
    v_xor_b32 v176, v176, v12
    v_lshl_add_u32 v176, v176, 4, v11
    v_add_u32 v176, v13, v176
    v_lshl_add_u32 v1, s43, 1, v1
    v_add_u32 v12, 1, v1
    v_bfe_u32 v12, v12, 2, 2
    v_mad_u32_u24 v11, v1, s29, v15
    v_lshl_add_u32 v11, v3, 3, v11
    v_add_u32 v13, 9728, v11
    v_add_u32 v14, s28, v4
    v_xor_b32 v15, v14, v12
    v_lshl_add_u32 v177, v15, 4, v11
    v_add_u32 v14, 1, v14
    v_xor_b32 v15, v14, v12
    v_lshl_add_u32 v179, v15, 4, v13
    v_cndmask_b32 v14, 0, 2, vcc
    v_cndmask_b32 v13, v13, v11, vcc
    v_add_u32 v14, s28, v14
    v_xor_b32 v15, v14, v12
    v_lshl_add_u32 v178, v15, 4, v13
    v_bfe_u32 v11, v0, 2, 2
    v_mul_u32_u24 v11, 48, v11
    v_add_u32 v11, s33, v11
    v_and_b32 v12, 3, v0
    v_lshl_add_u32 v11, v12, 3, v11
    v_mul_u32_u24 v13, 384, v4
    v_mad_u32_u24 v13, v3, s30, v13
    v_mul_u32_u24 v14, 384, v7
    v_mad_u32_u24 v14, v6, s30, v14
    v_add_u32 v144, v11, v13
    v_add_u32 v145, v11, v14
    v_cmp_lt_u32 vcc, 1, v12
    s_add_u32 s30, s33, 3456
    v_mov_b32 v155, s30
    v_mov_b32 v13, 32
    v_mov_b32 v14, -4112
    v_cndmask_b32 v13, v13, v14, vcc
    v_cndmask_b32 v15, 0, 1, vcc
    v_add_u32 v146, v144, v13
    v_add_u32 v147, v145, v13
    v_cndmask_b32 v148, v146, v155, vcc
    v_cndmask_b32 v149, v147, v155, vcc
    v_add_u32 v150, 12288, v146
    v_add_u32 v151, 12288, v147
    v_cndmask_b32 v150, v155, v150, vcc
    v_cndmask_b32 v151, v155, v151, vcc
    v_lshl_add_u32 v11, v2, 12, v11
    v_add_u32 v11, 3072, v11
    v_sub_u32 v15, v2, v15
    v_cmp_gt_u32 vcc, 3, v15
    v_add_u32 v153, v11, v13
    v_add_u32 v154, -4080, v11
    v_cndmask_b32 v153, v155, v153, vcc
    v_cmp_gt_u32 vcc, 3, v2
    s_nop 1
    v_cndmask_b32 v152, v155, v11, vcc
    v_cmp_lt_u32 vcc, 0, v2
    s_nop 0
    v_mov_b32 v10, 1
    v_cndmask_b32 v154, v155, v154, vcc
    s_waitcnt vmcnt(8)
    ds_read_b64_tr_b16 v[16:17], v144 offset:0
    ds_read_b64_tr_b16 v[18:19], v144 offset:192
    ds_read_b64_tr_b16 v[24:25], v145 offset:0
    ds_read_b64_tr_b16 v[26:27], v145 offset:192
    ds_read_b64_tr_b16 v[20:21], v148 offset:0
    ds_read_b64_tr_b16 v[22:23], v148 offset:192
    ds_read_b64_tr_b16 v[28:29], v149 offset:0
    ds_read_b64_tr_b16 v[30:31], v149 offset:192
    ds_read_b64_tr_b16 v[40:41], v144 offset:16
    ds_read_b64_tr_b16 v[42:43], v144 offset:208
    ds_read_b64_tr_b16 v[52:53], v145 offset:16
    ds_read_b64_tr_b16 v[54:55], v145 offset:208
    s_waitcnt vmcnt(4)
    ds_read_b64_tr_b16 v[32:33], v144 offset:4096
    ds_read_b64_tr_b16 v[34:35], v144 offset:4288
    ds_read_b64_tr_b16 v[44:45], v145 offset:4096
    ds_read_b64_tr_b16 v[46:47], v145 offset:4288
    ds_read_b64_tr_b16 v[36:37], v146 offset:4096
    ds_read_b64_tr_b16 v[38:39], v146 offset:4288
    ds_read_b64_tr_b16 v[48:49], v147 offset:4096
    ds_read_b64_tr_b16 v[50:51], v147 offset:4288
    ds_read_b64_tr_b16 v[76:77], v144 offset:4112
    ds_read_b64_tr_b16 v[78:79], v144 offset:4304
    ds_read_b64_tr_b16 v[88:89], v145 offset:4112
    ds_read_b64_tr_b16 v[90:91], v145 offset:4304
    s_waitcnt vmcnt(0)
    ds_read_b64_tr_b16 v[56:57], v152 offset:0
    ds_read_b64_tr_b16 v[58:59], v152 offset:192
    ds_read_b64_tr_b16 v[60:61], v153 offset:0
    ds_read_b64_tr_b16 v[62:63], v153 offset:192
    ds_read_b64_tr_b16 v[64:65], v154 offset:0
    ds_read_b64_tr_b16 v[66:67], v154 offset:192
    ds_read_b64_tr_b16 v[68:69], v144 offset:8192
    ds_read_b64_tr_b16 v[70:71], v144 offset:8384
    ds_read_b64_tr_b16 v[80:81], v145 offset:8192
    ds_read_b64_tr_b16 v[82:83], v145 offset:8384
    ds_read_b64_tr_b16 v[72:73], v146 offset:8192
    ds_read_b64_tr_b16 v[74:75], v146 offset:8384
    ds_read_b64_tr_b16 v[84:85], v147 offset:8192
    ds_read_b64_tr_b16 v[86:87], v147 offset:8384
    ds_read_b64_tr_b16 v[92:93], v150 offset:0
    ds_read_b64_tr_b16 v[94:95], v150 offset:192
    ds_read_b64_tr_b16 v[100:101], v151 offset:0
    ds_read_b64_tr_b16 v[102:103], v151 offset:192
    ds_read_b64_tr_b16 v[96:97], v144 offset:8208
    ds_read_b64_tr_b16 v[98:99], v144 offset:8400
    ds_read_b64_tr_b16 v[104:105], v145 offset:8208
    ds_read_b64_tr_b16 v[106:107], v145 offset:8400
    ds_write_b32 v8, v10
    s_mov_b32 s37, 0
    v_and_b32 v11, -9, v9
    v_lshl_add_u32 v11, s43, 3, v11
    v_mov_b32 v5, 0
    s_mov_b32 s35, 8
    s_mov_b32 s34, 8
L_c_loop:
    v_cmp_gt_i32 vcc, s35, v5
    s_cbranch_vccnz L_c_slow0
L_c_ready0:
    s_mov_b32 s35, s34
    s_mov_b32 s34, 35
    ds_read_b128 v[108:111], v174 offset:0
    ds_read_b128 v[112:115], v175 offset:0
    ds_read_b128 v[116:119], v174 offset:9728
    ds_read_b128 v[120:123], v175 offset:9728
    ds_read_b128 v[124:127], v174 offset:19456
    ds_read_b128 v[128:131], v175 offset:19456
    ds_read_b128 v[132:135], v174 offset:29184
    ds_read_b128 v[136:139], v175 offset:29184
    ds_read_b128 v[140:143], v176 offset:0
    s_waitcnt lgkmcnt(5)
    v_mfma_f32_16x16x32_bf16 v[144:147], v[16:19], v[108:111], 0
    v_mfma_f32_16x16x32_bf16 v[148:151], v[20:23], v[108:111], 0
    v_mfma_f32_16x16x32_bf16 v[144:147], v[24:27], v[112:115], v[144:147]
    v_mfma_f32_16x16x32_bf16 v[148:151], v[28:31], v[112:115], v[148:151]
    v_mfma_f32_16x16x32_bf16 v[144:147], v[32:35], v[116:119], v[144:147]
    v_mfma_f32_16x16x32_bf16 v[148:151], v[36:39], v[116:119], v[148:151]
    v_mfma_f32_16x16x32_bf16 v[152:155], v[40:43], v[116:119], 0
    v_mfma_f32_16x16x32_bf16 v[144:147], v[44:47], v[120:123], v[144:147]
    v_mfma_f32_16x16x32_bf16 v[148:151], v[48:51], v[120:123], v[148:151]
    v_mfma_f32_16x16x32_bf16 v[152:155], v[52:55], v[120:123], v[152:155]
    s_waitcnt lgkmcnt(0)
    v_mfma_f32_16x16x32_bf16 v[144:147], v[68:71], v[124:127], v[144:147]
    v_mfma_f32_16x16x32_bf16 v[148:151], v[72:75], v[124:127], v[148:151]
    v_mfma_f32_16x16x32_bf16 v[152:155], v[76:79], v[124:127], v[152:155]
    v_mfma_f32_16x16x32_bf16 v[144:147], v[80:83], v[128:131], v[144:147]
    v_mfma_f32_16x16x32_bf16 v[148:151], v[84:87], v[128:131], v[148:151]
    v_mfma_f32_16x16x32_bf16 v[152:155], v[88:91], v[128:131], v[152:155]
    v_mfma_f32_16x16x32_bf16 v[148:151], v[92:95], v[132:135], v[148:151]
    v_mfma_f32_16x16x32_bf16 v[152:155], v[96:99], v[132:135], v[152:155]
    v_mfma_f32_16x16x32_bf16 v[148:151], v[100:103], v[136:139], v[148:151]
    v_mfma_f32_16x16x32_bf16 v[152:155], v[104:107], v[136:139], v[152:155]
    v_mfma_f32_16x16x32_bf16 v[144:147], v[56:59], v[140:143], v[144:147]
    v_mfma_f32_16x16x32_bf16 v[148:151], v[60:63], v[140:143], v[148:151]
    v_mfma_f32_16x16x32_bf16 v[152:155], v[64:67], v[140:143], v[152:155]
    v_cmp_gt_i32 vcc, 12, v5
    s_cbranch_vccnz L_c_slow1
L_c_ready1:
    v_mfma_f32_16x16x32_bf16 v[156:159], v[16:19], v[124:127], 0
    ds_read_b128 v[108:111], v174 offset:38912
    v_mfma_f32_16x16x32_bf16 v[160:163], v[20:23], v[124:127], 0
    ds_read_b128 v[112:115], v175 offset:38912
    v_mfma_f32_16x16x32_bf16 v[156:159], v[24:27], v[128:131], v[156:159]
    ds_read_b128 v[116:119], v174 offset:48640
    v_add_u32 v10, 1, v10
    v_mfma_f32_16x16x32_bf16 v[160:163], v[28:31], v[128:131], v[160:163]
    ds_read_b128 v[120:123], v175 offset:48640
    v_cvt_pk_bf16_f32 v168, v144, v145
    v_mfma_f32_16x16x32_bf16 v[156:159], v[32:35], v[132:135], v[156:159]
    ds_read_b128 v[140:143], v176 offset:19456
    v_cvt_pk_bf16_f32 v169, v146, v147
    v_mfma_f32_16x16x32_bf16 v[160:163], v[36:39], v[132:135], v[160:163]
    ds_write_b64 v177, v[168:169] offset:0
    v_mfma_f32_16x16x32_bf16 v[164:167], v[40:43], v[132:135], 0
    v_cvt_pk_bf16_f32 v170, v148, v149
    v_cvt_pk_bf16_f32 v171, v150, v151
    v_mfma_f32_16x16x32_bf16 v[156:159], v[44:47], v[136:139], v[156:159]
    ds_write_b64 v178, v[170:171] offset:0
    v_mfma_f32_16x16x32_bf16 v[160:163], v[48:51], v[136:139], v[160:163]
    v_cvt_pk_bf16_f32 v172, v152, v153
    v_cvt_pk_bf16_f32 v173, v154, v155
    v_mfma_f32_16x16x32_bf16 v[164:167], v[52:55], v[136:139], v[164:167]
    s_waitcnt lgkmcnt(2)
    v_mfma_f32_16x16x32_bf16 v[156:159], v[68:71], v[108:111], v[156:159]
    ds_write_b64 v179, v[172:173] offset:0
    v_mfma_f32_16x16x32_bf16 v[160:163], v[72:75], v[108:111], v[160:163]
    ds_write_b32 v8, v10
    v_mfma_f32_16x16x32_bf16 v[164:167], v[76:79], v[108:111], v[164:167]
    v_add_u32 v174, 38912, v174
    v_add_u32 v175, 38912, v175
    v_mfma_f32_16x16x32_bf16 v[156:159], v[80:83], v[112:115], v[156:159]
    v_add_u32 v176, 38912, v176
    v_mfma_f32_16x16x32_bf16 v[160:163], v[84:87], v[112:115], v[160:163]
    v_mfma_f32_16x16x32_bf16 v[164:167], v[88:91], v[112:115], v[164:167]
    v_mfma_f32_16x16x32_bf16 v[160:163], v[92:95], v[116:119], v[160:163]
    v_mfma_f32_16x16x32_bf16 v[164:167], v[96:99], v[116:119], v[164:167]
    v_mfma_f32_16x16x32_bf16 v[160:163], v[100:103], v[120:123], v[160:163]
    v_mfma_f32_16x16x32_bf16 v[164:167], v[104:107], v[120:123], v[164:167]
    v_mfma_f32_16x16x32_bf16 v[156:159], v[56:59], v[140:143], v[156:159]
    v_mfma_f32_16x16x32_bf16 v[160:163], v[60:63], v[140:143], v[160:163]
    v_mfma_f32_16x16x32_bf16 v[164:167], v[64:67], v[140:143], v[164:167]
    v_cmp_gt_i32 vcc, 16, v5
    s_cbranch_vccnz L_c_slow2
L_c_ready2:
    v_mfma_f32_16x16x32_bf16 v[144:147], v[16:19], v[108:111], 0
    ds_read_b128 v[124:127], v174 offset:19456
    v_mfma_f32_16x16x32_bf16 v[148:151], v[20:23], v[108:111], 0
    ds_read_b128 v[128:131], v175 offset:19456
    v_mfma_f32_16x16x32_bf16 v[144:147], v[24:27], v[112:115], v[144:147]
    ds_read_b128 v[132:135], v174 offset:29184
    v_add_u32 v10, 1, v10
    v_mfma_f32_16x16x32_bf16 v[148:151], v[28:31], v[112:115], v[148:151]
    ds_read_b128 v[136:139], v175 offset:29184
    v_cvt_pk_bf16_f32 v168, v156, v157
    v_mfma_f32_16x16x32_bf16 v[144:147], v[32:35], v[116:119], v[144:147]
    ds_read_b128 v[140:143], v176 offset:0
    v_cvt_pk_bf16_f32 v169, v158, v159
    v_mfma_f32_16x16x32_bf16 v[148:151], v[36:39], v[116:119], v[148:151]
    ds_write_b64 v177, v[168:169] offset:19456
    v_mfma_f32_16x16x32_bf16 v[152:155], v[40:43], v[116:119], 0
    v_cvt_pk_bf16_f32 v170, v160, v161
    v_cvt_pk_bf16_f32 v171, v162, v163
    v_mfma_f32_16x16x32_bf16 v[144:147], v[44:47], v[120:123], v[144:147]
    ds_write_b64 v178, v[170:171] offset:19456
    v_mfma_f32_16x16x32_bf16 v[148:151], v[48:51], v[120:123], v[148:151]
    v_cvt_pk_bf16_f32 v172, v164, v165
    v_cvt_pk_bf16_f32 v173, v166, v167
    v_mfma_f32_16x16x32_bf16 v[152:155], v[52:55], v[120:123], v[152:155]
    s_waitcnt lgkmcnt(2)
    v_mfma_f32_16x16x32_bf16 v[144:147], v[68:71], v[124:127], v[144:147]
    ds_write_b64 v179, v[172:173] offset:19456
    v_mfma_f32_16x16x32_bf16 v[148:151], v[72:75], v[124:127], v[148:151]
    ds_write_b32 v8, v10
    v_mfma_f32_16x16x32_bf16 v[152:155], v[76:79], v[124:127], v[152:155]
    v_add_u32 v177, 38912, v177
    v_add_u32 v178, 38912, v178
    v_mfma_f32_16x16x32_bf16 v[144:147], v[80:83], v[128:131], v[144:147]
    v_add_u32 v179, 38912, v179
    v_mfma_f32_16x16x32_bf16 v[148:151], v[84:87], v[128:131], v[148:151]
    v_mfma_f32_16x16x32_bf16 v[152:155], v[88:91], v[128:131], v[152:155]
    v_mfma_f32_16x16x32_bf16 v[148:151], v[92:95], v[132:135], v[148:151]
    v_mfma_f32_16x16x32_bf16 v[152:155], v[96:99], v[132:135], v[152:155]
    v_mfma_f32_16x16x32_bf16 v[148:151], v[100:103], v[136:139], v[148:151]
    v_mfma_f32_16x16x32_bf16 v[152:155], v[104:107], v[136:139], v[152:155]
    v_mfma_f32_16x16x32_bf16 v[144:147], v[56:59], v[140:143], v[144:147]
    v_mfma_f32_16x16x32_bf16 v[148:151], v[60:63], v[140:143], v[148:151]
    v_mfma_f32_16x16x32_bf16 v[152:155], v[64:67], v[140:143], v[152:155]
    v_cmp_gt_i32 vcc, 20, v5
    s_cbranch_vccnz L_c_slow3
L_c_ready3:
    v_mfma_f32_16x16x32_bf16 v[156:159], v[16:19], v[124:127], 0
    ds_read_b128 v[108:111], v174 offset:38912
    v_mfma_f32_16x16x32_bf16 v[160:163], v[20:23], v[124:127], 0
    ds_read_b128 v[112:115], v175 offset:38912
    v_mfma_f32_16x16x32_bf16 v[156:159], v[24:27], v[128:131], v[156:159]
    ds_read_b128 v[116:119], v174 offset:48640
    v_add_u32 v10, 1, v10
    v_mfma_f32_16x16x32_bf16 v[160:163], v[28:31], v[128:131], v[160:163]
    ds_read_b128 v[120:123], v175 offset:48640
    v_cvt_pk_bf16_f32 v168, v144, v145
    v_mfma_f32_16x16x32_bf16 v[156:159], v[32:35], v[132:135], v[156:159]
    ds_read_b128 v[140:143], v176 offset:19456
    v_cvt_pk_bf16_f32 v169, v146, v147
    v_mfma_f32_16x16x32_bf16 v[160:163], v[36:39], v[132:135], v[160:163]
    ds_write_b64 v177, v[168:169] offset:0
    v_mfma_f32_16x16x32_bf16 v[164:167], v[40:43], v[132:135], 0
    v_cvt_pk_bf16_f32 v170, v148, v149
    v_cvt_pk_bf16_f32 v171, v150, v151
    v_mfma_f32_16x16x32_bf16 v[156:159], v[44:47], v[136:139], v[156:159]
    ds_write_b64 v178, v[170:171] offset:0
    v_mfma_f32_16x16x32_bf16 v[160:163], v[48:51], v[136:139], v[160:163]
    v_cvt_pk_bf16_f32 v172, v152, v153
    v_cvt_pk_bf16_f32 v173, v154, v155
    v_mfma_f32_16x16x32_bf16 v[164:167], v[52:55], v[136:139], v[164:167]
    s_waitcnt lgkmcnt(2)
    v_mfma_f32_16x16x32_bf16 v[156:159], v[68:71], v[108:111], v[156:159]
    ds_write_b64 v179, v[172:173] offset:0
    v_mfma_f32_16x16x32_bf16 v[160:163], v[72:75], v[108:111], v[160:163]
    ds_write_b32 v8, v10
    v_mfma_f32_16x16x32_bf16 v[164:167], v[76:79], v[108:111], v[164:167]
    v_add_u32 v174, 38912, v174
    v_add_u32 v175, 38912, v175
    v_mfma_f32_16x16x32_bf16 v[156:159], v[80:83], v[112:115], v[156:159]
    v_add_u32 v176, 38912, v176
    v_mfma_f32_16x16x32_bf16 v[160:163], v[84:87], v[112:115], v[160:163]
    v_mfma_f32_16x16x32_bf16 v[164:167], v[88:91], v[112:115], v[164:167]
    v_mfma_f32_16x16x32_bf16 v[160:163], v[92:95], v[116:119], v[160:163]
    v_mfma_f32_16x16x32_bf16 v[164:167], v[96:99], v[116:119], v[164:167]
    v_mfma_f32_16x16x32_bf16 v[160:163], v[100:103], v[120:123], v[160:163]
    v_mfma_f32_16x16x32_bf16 v[164:167], v[104:107], v[120:123], v[164:167]
    v_mfma_f32_16x16x32_bf16 v[156:159], v[56:59], v[140:143], v[156:159]
    v_mfma_f32_16x16x32_bf16 v[160:163], v[60:63], v[140:143], v[160:163]
    v_mfma_f32_16x16x32_bf16 v[164:167], v[64:67], v[140:143], v[164:167]
    v_cmp_gt_i32 vcc, 24, v5
    s_cbranch_vccnz L_c_slow4
L_c_ready4:
    v_mfma_f32_16x16x32_bf16 v[144:147], v[16:19], v[108:111], 0
    ds_read_b128 v[124:127], v174 offset:19456
    v_mfma_f32_16x16x32_bf16 v[148:151], v[20:23], v[108:111], 0
    ds_read_b128 v[128:131], v175 offset:19456
    v_mfma_f32_16x16x32_bf16 v[144:147], v[24:27], v[112:115], v[144:147]
    ds_read_b128 v[132:135], v174 offset:29184
    v_add_u32 v10, 1, v10
    v_mfma_f32_16x16x32_bf16 v[148:151], v[28:31], v[112:115], v[148:151]
    ds_read_b128 v[136:139], v175 offset:29184
    v_cvt_pk_bf16_f32 v168, v156, v157
    v_mfma_f32_16x16x32_bf16 v[144:147], v[32:35], v[116:119], v[144:147]
    ds_read_b128 v[140:143], v176 offset:0
    v_cvt_pk_bf16_f32 v169, v158, v159
    v_mfma_f32_16x16x32_bf16 v[148:151], v[36:39], v[116:119], v[148:151]
    ds_write_b64 v177, v[168:169] offset:19456
    v_mfma_f32_16x16x32_bf16 v[152:155], v[40:43], v[116:119], 0
    v_cvt_pk_bf16_f32 v170, v160, v161
    v_cvt_pk_bf16_f32 v171, v162, v163
    v_mfma_f32_16x16x32_bf16 v[144:147], v[44:47], v[120:123], v[144:147]
    ds_write_b64 v178, v[170:171] offset:19456
    v_mfma_f32_16x16x32_bf16 v[148:151], v[48:51], v[120:123], v[148:151]
    v_cvt_pk_bf16_f32 v172, v164, v165
    v_cvt_pk_bf16_f32 v173, v166, v167
    v_mfma_f32_16x16x32_bf16 v[152:155], v[52:55], v[120:123], v[152:155]
    s_waitcnt lgkmcnt(2)
    v_mfma_f32_16x16x32_bf16 v[144:147], v[68:71], v[124:127], v[144:147]
    ds_write_b64 v179, v[172:173] offset:19456
    v_mfma_f32_16x16x32_bf16 v[148:151], v[72:75], v[124:127], v[148:151]
    ds_write_b32 v8, v10
    v_mfma_f32_16x16x32_bf16 v[152:155], v[76:79], v[124:127], v[152:155]
    v_add_u32 v177, 38912, v177
    v_add_u32 v178, 38912, v178
    v_mfma_f32_16x16x32_bf16 v[144:147], v[80:83], v[128:131], v[144:147]
    v_add_u32 v179, 38912, v179
    v_mfma_f32_16x16x32_bf16 v[148:151], v[84:87], v[128:131], v[148:151]
    v_mfma_f32_16x16x32_bf16 v[152:155], v[88:91], v[128:131], v[152:155]
    v_mfma_f32_16x16x32_bf16 v[148:151], v[92:95], v[132:135], v[148:151]
    v_mfma_f32_16x16x32_bf16 v[152:155], v[96:99], v[132:135], v[152:155]
    v_mfma_f32_16x16x32_bf16 v[148:151], v[100:103], v[136:139], v[148:151]
    v_mfma_f32_16x16x32_bf16 v[152:155], v[104:107], v[136:139], v[152:155]
    v_mfma_f32_16x16x32_bf16 v[144:147], v[56:59], v[140:143], v[144:147]
    v_mfma_f32_16x16x32_bf16 v[148:151], v[60:63], v[140:143], v[148:151]
    v_mfma_f32_16x16x32_bf16 v[152:155], v[64:67], v[140:143], v[152:155]
    v_cmp_gt_i32 vcc, 28, v5
    s_cbranch_vccnz L_c_slow5
L_c_ready5:
    v_mfma_f32_16x16x32_bf16 v[156:159], v[16:19], v[124:127], 0
    ds_read_b128 v[108:111], v174 offset:38912
    v_mfma_f32_16x16x32_bf16 v[160:163], v[20:23], v[124:127], 0
    ds_read_b128 v[112:115], v175 offset:38912
    v_mfma_f32_16x16x32_bf16 v[156:159], v[24:27], v[128:131], v[156:159]
    ds_read_b128 v[116:119], v174 offset:48640
    v_add_u32 v10, 1, v10
    v_mfma_f32_16x16x32_bf16 v[160:163], v[28:31], v[128:131], v[160:163]
    ds_read_b128 v[120:123], v175 offset:48640
    v_cvt_pk_bf16_f32 v168, v144, v145
    v_mfma_f32_16x16x32_bf16 v[156:159], v[32:35], v[132:135], v[156:159]
    ds_read_b128 v[140:143], v176 offset:19456
    v_cvt_pk_bf16_f32 v169, v146, v147
    v_mfma_f32_16x16x32_bf16 v[160:163], v[36:39], v[132:135], v[160:163]
    ds_write_b64 v177, v[168:169] offset:0
    v_mfma_f32_16x16x32_bf16 v[164:167], v[40:43], v[132:135], 0
    v_cvt_pk_bf16_f32 v170, v148, v149
    v_cvt_pk_bf16_f32 v171, v150, v151
    v_mfma_f32_16x16x32_bf16 v[156:159], v[44:47], v[136:139], v[156:159]
    ds_write_b64 v178, v[170:171] offset:0
    v_mfma_f32_16x16x32_bf16 v[160:163], v[48:51], v[136:139], v[160:163]
    v_cvt_pk_bf16_f32 v172, v152, v153
    v_cvt_pk_bf16_f32 v173, v154, v155
    v_mfma_f32_16x16x32_bf16 v[164:167], v[52:55], v[136:139], v[164:167]
    s_waitcnt lgkmcnt(2)
    v_mfma_f32_16x16x32_bf16 v[156:159], v[68:71], v[108:111], v[156:159]
    ds_write_b64 v179, v[172:173] offset:0
    v_mfma_f32_16x16x32_bf16 v[160:163], v[72:75], v[108:111], v[160:163]
    ds_write_b32 v8, v10
    v_mfma_f32_16x16x32_bf16 v[164:167], v[76:79], v[108:111], v[164:167]
    v_add_u32 v174, s38, v174
    v_add_u32 v175, s38, v175
    v_mfma_f32_16x16x32_bf16 v[156:159], v[80:83], v[112:115], v[156:159]
    v_add_u32 v176, s38, v176
    s_add_u32 s37, s37, 1
    v_mfma_f32_16x16x32_bf16 v[160:163], v[84:87], v[112:115], v[160:163]
    v_mov_b32 v11, v9
    s_cmp_eq_u32 s37, 1
    v_mfma_f32_16x16x32_bf16 v[164:167], v[88:91], v[112:115], v[164:167]
    s_cselect_b32 s36, 0, -1
    v_and_b32 v5, s36, v5
    v_mfma_f32_16x16x32_bf16 v[160:163], v[92:95], v[116:119], v[160:163]
    s_cmp_lt_u32 s37, 3
    v_mfma_f32_16x16x32_bf16 v[164:167], v[96:99], v[116:119], v[164:167]
    v_mfma_f32_16x16x32_bf16 v[160:163], v[100:103], v[120:123], v[160:163]
    v_mfma_f32_16x16x32_bf16 v[164:167], v[104:107], v[120:123], v[164:167]
    v_mfma_f32_16x16x32_bf16 v[156:159], v[56:59], v[140:143], v[156:159]
    v_mfma_f32_16x16x32_bf16 v[160:163], v[60:63], v[140:143], v[160:163]
    v_mfma_f32_16x16x32_bf16 v[164:167], v[64:67], v[140:143], v[164:167]
    v_add_u32 v10, 1, v10
    s_nop 4
    v_cvt_pk_bf16_f32 v168, v156, v157
    v_cvt_pk_bf16_f32 v169, v158, v159
    ds_write_b64 v177, v[168:169] offset:19456
    v_cvt_pk_bf16_f32 v170, v160, v161
    v_cvt_pk_bf16_f32 v171, v162, v163
    ds_write_b64 v178, v[170:171] offset:19456
    v_cvt_pk_bf16_f32 v172, v164, v165
    v_cvt_pk_bf16_f32 v173, v166, v167
    ds_write_b64 v179, v[172:173] offset:19456
    ds_write_b32 v8, v10
    v_add_u32 v177, s38, v177
    v_add_u32 v178, s38, v178
    v_add_u32 v179, s38, v179
    s_cbranch_scc1 L_c_loop
L_end:
    s_endpgm
L_c_slow0:
L_poll5:
    ds_read_b32 v5, v11
    s_waitcnt lgkmcnt(0)
    v_cmp_gt_i32 vcc, s35, v5
    s_cbranch_vccz L_pdone6
    s_sleep 1
    s_branch L_poll5
L_pdone6:
    s_branch L_c_ready0
L_c_slow1:
L_poll7:
    ds_read_b32 v5, v11
    s_waitcnt lgkmcnt(0)
    v_cmp_gt_i32 vcc, 12, v5
    s_cbranch_vccz L_pdone8
    s_sleep 1
    s_branch L_poll7
L_pdone8:
    s_branch L_c_ready1
L_c_slow2:
L_poll9:
    ds_read_b32 v5, v11
    s_waitcnt lgkmcnt(0)
    v_cmp_gt_i32 vcc, 16, v5
    s_cbranch_vccz L_pdone10
    s_sleep 1
    s_branch L_poll9
L_pdone10:
    s_branch L_c_ready2
L_c_slow3:
L_poll11:
    ds_read_b32 v5, v11
    s_waitcnt lgkmcnt(0)
    v_cmp_gt_i32 vcc, 20, v5
    s_cbranch_vccz L_pdone12
    s_sleep 1
    s_branch L_poll11
L_pdone12:
    s_branch L_c_ready3
L_c_slow4:
L_poll13:
    ds_read_b32 v5, v11
    s_waitcnt lgkmcnt(0)
    v_cmp_gt_i32 vcc, 24, v5
    s_cbranch_vccz L_pdone14
    s_sleep 1
    s_branch L_poll13
L_pdone14:
    s_branch L_c_ready4
L_c_slow5:
L_poll15:
    ds_read_b32 v5, v11
    s_waitcnt lgkmcnt(0)
    v_cmp_gt_i32 vcc, 28, v5
    s_cbranch_vccz L_pdone16
    s_sleep 1
    s_branch L_poll15
L_pdone16:
    s_branch L_c_ready5
.section .rodata,"a"
.p2align 6
.amdhsa_kernel standalone__grouped__vision_kernel
  .amdhsa_next_free_vgpr 188
  .amdhsa_next_free_sgpr 102
  .amdhsa_accum_offset 188
  .amdhsa_group_segment_fixed_size 0
  .amdhsa_kernarg_size 40
  .amdhsa_user_sgpr_count 2
  .amdhsa_user_sgpr_kernarg_segment_ptr 1
  .amdhsa_system_sgpr_workgroup_id_x 1
.end_amdhsa_kernel
```
